```python
import torch

def _softmax(x, axis=-1):
    return torch.softmax(x, dim=axis)
def _gelu(x):
    return torch.nn.functional.gelu(x, approximate="tanh")
def _silu(x):
    return torch.nn.functional.silu(x)
def _sigmoid(x):
    return torch.sigmoid(x)
def _layernorm(x, axis=-1, eps=1e-5):
    m = x.mean(dim=axis, keepdim=True)
    v = x.var(dim=axis, keepdim=True, unbiased=False)
    return (x - m) / torch.sqrt(v + eps)
def _scatter_add(tgt, idx, src, axis=0):
    return tgt.clone().index_add_(axis, idx, src)
def _segment_sum(src, seg, n):
    out = torch.zeros((n,) + src.shape[1:], dtype=src.dtype)
    return out.index_add_(0, seg, src)
def _pad(x, pw):
    flat = tuple(v for pair in reversed(pw) for v in pair)
    return torch.nn.functional.pad(x, flat)

kernel_name = 'parallel_sum__sliding_block_cached__dense_activation_gelu__decode'

def setup_inputs():

    _w = (lambda a: (lambda t: t.to(torch.bfloat16) if t.is_floating_point() else t)(torch.as_tensor(a)))
    def _A_setup():
        B, Sq, D = 1, 1, 640
        Hq, Hkv, Sk, Dh = 32, 32, 8192, 128
        assert Hq % Hkv == 0, (Hq, Hkv)
        return {
            "x": _w((lambda *s: torch.randn(*s, dtype=torch.bfloat16) * 0.05)(B, Sq, D)),
            "k_cache": _w((lambda *s: torch.randn(*s, dtype=torch.bfloat16) * 3.2)(B, Hkv, Sk, Dh)),
            "v_cache": _w((lambda *s: torch.randn(*s, dtype=torch.bfloat16) * 0.8)(B, Hkv, Sk, Dh)),
            "wq": _w((lambda *s: torch.randn(*s, dtype=torch.bfloat16) * 3.2)(D, Hq * Dh) * (D ** -0.5)),
            "wo": _w((lambda *s: torch.randn(*s, dtype=torch.bfloat16) * 0.8)(Hq * Dh, D) * ((Hq * Dh) ** -0.5)),
        }
    _A_in = _A_setup()

    def _B_setup():
        B, S, D, F = 1, 1, 640, 1728
        return {
            "x": _w((lambda *s: torch.randn(*s, dtype=torch.bfloat16) * 0.05)(B, S, D)),
            "w1": _w((lambda *s: torch.randn(*s, dtype=torch.bfloat16) * 0.8)(D, F) * (D ** -0.5)),
            "b1": _w((lambda *s: torch.randn(*s, dtype=torch.bfloat16) * 0.8)(F) * 0.01),
            "w2": _w((lambda *s: torch.randn(*s, dtype=torch.bfloat16) * 0.8)(F, D) * (F ** -0.5)),
            "b2": _w((lambda *s: torch.randn(*s, dtype=torch.bfloat16) * 0.8)(D) * 0.01),
        }
    _B_in = _B_setup()

    return {
        "A_x": _A_in["x"],
        "A_k_cache": _A_in["k_cache"],
        "A_v_cache": _A_in["v_cache"],
        "A_wq": _A_in["wq"],
        "A_wo": _A_in["wo"],
        "B_x": _B_in["x"],
        "B_w1": _B_in["w1"],
        "B_b1": _B_in["b1"],
        "B_w2": _B_in["w2"],
        "B_b2": _B_in["b2"],
    }

def reference(A_x, A_k_cache, A_v_cache, A_wq, A_wo, B_x, B_w1, B_b1, B_w2, B_b2):
    def _A_ref(x, k_cache, v_cache, wq, wo):
        B, Sq, D = x.shape
        Hq, Dh = 32, 128
        Hkv, Sk = k_cache.shape[1], k_cache.shape[2]
        W = min(4096, max(256, Sk // 4))
        rep = Hq // Hkv
        q = (lambda x, *d: x.permute(*d))((x @ wq).reshape(B, Sq, Hq, Dh), 0, 2, 1, 3)
        k = (lambda x, n, axis: torch.repeat_interleave(x, n, dim=axis))(k_cache[:, :, Sk - W:, :], rep, axis=1)
        v = (lambda x, n, axis: torch.repeat_interleave(x, n, dim=axis))(v_cache[:, :, Sk - W:, :], rep, axis=1)
        scores = torch.einsum("bhqd,bhkd->bhqk", q, k) * (Dh ** -0.5)
        p = _softmax(scores, axis=-1)
        o = torch.einsum("bhqk,bhkd->bhqd", p, v)
        return (lambda x, *d: x.permute(*d))(o, 0, 2, 1, 3).reshape(B, Sq, Hq * Dh) @ wo

    def _B_ref(x, w1, b1, w2, b2):
        h = torch.einsum("bsd,df->bsf", x, w1) + b1
        h = _gelu(h)
        return torch.einsum("bsf,fd->bsd", h, w2) + b2

    x = A_x
    xn = _layernorm(x, axis=-1)
    return x + _A_ref(xn, A_k_cache, A_v_cache, A_wq, A_wo) + _B_ref(xn, B_w1, B_b1, B_w2, B_b2)
```

```asm
; @launch grid=(256,1,1) block=(512,1,1) lds=13312
.amdgcn_target "amdgcn-amd-amdhsa--gfx950"
.text
.globl parallel_sum__sliding_block_cached__dense_activation_gelu__decode_kernel
.p2align 8
.type parallel_sum__sliding_block_cached__dense_activation_gelu__decode_kernel,@function
parallel_sum__sliding_block_cached__dense_activation_gelu__decode_kernel:
    s_cmp_ge_u32 s2, 256
    s_cbranch_scc1 L_END
    s_load_dwordx2 s[4:5], s[0:1], 0
    s_load_dwordx2 s[16:17], s[0:1], 24
    s_load_dwordx2 s[8:9], s[0:1], 8
    s_load_dwordx2 s[12:13], s[0:1], 16
    s_load_dwordx2 s[24:25], s[0:1], 48
    s_load_dwordx2 s[40:41], s[0:1], 96
    v_lshrrev_b32 v4, 6, v0
    v_and_b32 v1, 63, v0
    v_readfirstlane_b32 s46, v4
    s_and_b32 s44, s2, 31
    s_lshr_b32 s45, s2, 5
    v_lshlrev_b32 v26, 4, v1
    v_lshrrev_b32 v2, 4, v1
    v_and_b32 v3, 15, v1
    v_lshlrev_b32 v27, 4, v3
    s_mov_b32 s42, 0x10000000
    s_mov_b32 s43, 0x20000
    s_mov_b32 s3, 0x1000000
    s_cmp_ge_u32 s46, 4
    s_cbranch_scc1 L_KV
    s_setprio 3
    s_mov_b32 s18, 0x500000
    s_mov_b32 s19, 0x20000
    s_movk_i32 s6, 1280
    s_mov_b32 s7, 0x20000
    v_lshl_add_u32 v20, v2, 13, v27
    s_lshl_b32 s52, s45, 2
    s_add_u32 s52, s52, s46
    s_mul_i32 s56, s52, 163840
    s_lshl_b32 s50, s44, 8
    s_add_u32 s56, s56, s50
    v_lshlrev_b32 v5, 2, v1
    v_mov_b32 v12, 0xff800000
    v_mov_b32 v13, 0
    v_mov_b32 v14, 0
    v_mov_b32 v15, 0
    v_mov_b32 v8, 0
    v_mov_b32 v9, 0
    v_mov_b32 v10, 0
    v_mov_b32 v11, 0
    ds_write_b128 v13, v[12:15] offset:13056
    ds_write_b128 v13, v[8:11] offset:13088
    ds_write_b128 v13, v[8:11] offset:13104
    s_waitcnt lgkmcnt(0)
    buffer_load_dwordx4 v[30:33], v26, s[4:7], 0 offen
    buffer_load_dword v34, v5, s[4:7], 0 offen offset:1024
    buffer_load_dword v29, v13, s[40:43], 0 offen offset:0 sc1
    buffer_load_dwordx4 v[76:79], v20, s[16:19], s56 offen nt
    s_add_u32 s56, s56, 0x8000
    buffer_load_dwordx4 v[80:83], v20, s[16:19], s56 offen nt
    s_add_u32 s56, s56, 0x8000
    buffer_load_dwordx4 v[84:87], v20, s[16:19], s56 offen nt
    s_add_u32 s56, s56, 0x8000
    buffer_load_dwordx4 v[88:91], v20, s[16:19], s56 offen nt
    s_add_u32 s56, s56, 0x8000
    buffer_load_dwordx4 v[92:95], v20, s[16:19], s56 offen nt
    s_barrier
    s_branch L_AUX2
L_KV:
    s_mov_b32 s10, 0x4000000
    s_mov_b32 s11, 0x20000
    s_lshl_b32 s68, s44, 21
    s_lshl_b32 s50, s45, 12
    s_add_u32 s68, s68, s50
    s_lshl_b32 s50, s46, 15
    s_add_u32 s68, s68, s50
    s_add_u32 s68, s68, 0x160000
    s_add_u32 s69, s68, 0x20000
    s_add_u32 s70, s68, 0x40000
    s_add_u32 s71, s68, 0x60000
    v_lshrrev_b32 v6, 2, v3
    v_lshlrev_b32 v20, 8, v6
    v_and_b32 v7, 3, v3
    v_lshlrev_b32 v22, 4, v7
    v_lshl_add_u32 v22, v2, 6, v22
    v_add_u32 v20, v20, v22
    v_mov_b32 v23, 0
    s_cmp_lt_u32 s2, 232
    s_cbranch_scc1 L_NOPF
    s_cmp_lg_u32 s46, 4
    s_cbranch_scc1 L_NOPF
    s_getpc_b64 s[60:61]
L_PC:
    global_load_dwordx4 v[208:211], v26, s[60:61] offset:0
    global_load_dwordx4 v[208:211], v26, s[60:61] offset:1024
    global_load_dwordx4 v[208:211], v26, s[60:61] offset:2048
    global_load_dwordx4 v[208:211], v26, s[60:61] offset:3072
    s_add_u32 s60, s60, 4096
    s_addc_u32 s61, s61, 0
    global_load_dwordx4 v[208:211], v26, s[60:61] offset:0
    global_load_dwordx4 v[208:211], v26, s[60:61] offset:1024
    global_load_dwordx4 v[208:211], v26, s[60:61] offset:2048
    s_add_u32 s60, s60, L_END-L_PC-5116
    s_addc_u32 s61, s61, 0
    global_load_dwordx4 v[208:211], v26, s[60:61]
L_NOPF:
    s_setprio 2
    s_waitcnt lgkmcnt(0)
    s_barrier
    buffer_load_dwordx4 v[80:83], v20, s[8:11], s68 offen offset:0 nt
    buffer_load_dwordx4 v[84:87], v20, s[8:11], s68 offen offset:1024 nt
    buffer_load_dwordx4 v[88:91], v20, s[8:11], s68 offen offset:2048 nt
    buffer_load_dwordx4 v[92:95], v20, s[8:11], s68 offen offset:3072 nt
    buffer_load_dwordx4 v[96:99], v20, s[8:11], s69 offen offset:0 nt
    buffer_load_dwordx4 v[100:103], v20, s[8:11], s69 offen offset:1024 nt
    s_branch L_TH
L_KF6:
    buffer_load_dwordx4 v[104:107], v20, s[8:11], s69 offen offset:2048 nt
L_KF7:
    buffer_load_dwordx4 v[108:111], v20, s[8:11], s69 offen offset:3072 nt
L_KF8:
    buffer_load_dwordx4 v[112:115], v20, s[8:11], s70 offen offset:0 nt
L_KF9:
    buffer_load_dwordx4 v[116:119], v20, s[8:11], s70 offen offset:1024 nt
L_KF10:
    buffer_load_dwordx4 v[120:123], v20, s[8:11], s70 offen offset:2048 nt
L_KF11:
    buffer_load_dwordx4 v[124:127], v20, s[8:11], s70 offen offset:3072 nt
L_KF12:
    buffer_load_dwordx4 v[128:131], v20, s[8:11], s71 offen offset:0 nt
L_KF13:
    buffer_load_dwordx4 v[132:135], v20, s[8:11], s71 offen offset:1024 nt
L_KF14:
    buffer_load_dwordx4 v[136:139], v20, s[8:11], s71 offen offset:2048 nt
L_KF15:
    buffer_load_dwordx4 v[140:143], v20, s[8:11], s71 offen offset:3072 nt
L_KF16:
    s_setprio 1
    s_mov_b32 s14, 0x4000000
    s_mov_b32 s15, 0x20000
    v_lshl_add_u32 v21, v2, 10, v27
    buffer_load_dwordx4 v[144:147], v21, s[12:15], s68 offen offset:0 nt
    buffer_load_dwordx4 v[148:151], v21, s[12:15], s68 offen offset:256 nt
    buffer_load_dwordx4 v[152:155], v21, s[12:15], s68 offen offset:512 nt
    buffer_load_dwordx4 v[156:159], v21, s[12:15], s68 offen offset:768 nt
    buffer_load_dwordx4 v[160:163], v21, s[12:15], s69 offen offset:0 nt
    buffer_load_dwordx4 v[164:167], v21, s[12:15], s69 offen offset:256 nt
    buffer_load_dwordx4 v[168:171], v21, s[12:15], s69 offen offset:512 nt
    buffer_load_dwordx4 v[172:175], v21, s[12:15], s69 offen offset:768 nt
    buffer_load_dwordx4 v[176:179], v21, s[12:15], s70 offen offset:0 nt
    buffer_load_dwordx4 v[180:183], v21, s[12:15], s70 offen offset:256 nt
    buffer_load_dwordx4 v[184:187], v21, s[12:15], s70 offen offset:512 nt
    buffer_load_dwordx4 v[188:191], v21, s[12:15], s70 offen offset:768 nt
    buffer_load_dwordx4 v[192:195], v21, s[12:15], s71 offen offset:0 nt
    buffer_load_dwordx4 v[196:199], v21, s[12:15], s71 offen offset:256 nt
    buffer_load_dwordx4 v[200:203], v21, s[12:15], s71 offen offset:512 nt
    buffer_load_dwordx4 v[204:207], v21, s[12:15], s71 offen offset:768 nt
    s_branch L_KV2
L_TH:
    ds_read_b32 v6, v23 offset:13060
    s_waitcnt vmcnt(5) lgkmcnt(0)
    v_cmp_gt_u32 vcc, 5, v6
    s_cbranch_vccz L_KF6
    buffer_load_dwordx4 v[104:107], v20, s[8:11], s69 offen offset:2048 nt
    ds_read_b32 v6, v23 offset:13060
    s_waitcnt vmcnt(5) lgkmcnt(0)
    v_cmp_gt_u32 vcc, 5, v6
    s_cbranch_vccz L_KF7
    buffer_load_dwordx4 v[108:111], v20, s[8:11], s69 offen offset:3072 nt
    ds_read_b32 v6, v23 offset:13060
    s_waitcnt vmcnt(5) lgkmcnt(0)
    v_cmp_gt_u32 vcc, 5, v6
    s_cbranch_vccz L_KF8
    buffer_load_dwordx4 v[112:115], v20, s[8:11], s70 offen offset:0 nt
    ds_read_b32 v6, v23 offset:13060
    s_waitcnt vmcnt(5) lgkmcnt(0)
    v_cmp_gt_u32 vcc, 5, v6
    s_cbranch_vccz L_KF9
    buffer_load_dwordx4 v[116:119], v20, s[8:11], s70 offen offset:1024 nt
    ds_read_b32 v6, v23 offset:13060
    s_waitcnt vmcnt(5) lgkmcnt(0)
    v_cmp_gt_u32 vcc, 5, v6
    s_cbranch_vccz L_KF10
    buffer_load_dwordx4 v[120:123], v20, s[8:11], s70 offen offset:2048 nt
    ds_read_b32 v6, v23 offset:13060
    s_waitcnt vmcnt(5) lgkmcnt(0)
    v_cmp_gt_u32 vcc, 5, v6
    s_cbranch_vccz L_KF11
    buffer_load_dwordx4 v[124:127], v20, s[8:11], s70 offen offset:3072 nt
    ds_read_b32 v6, v23 offset:13060
    s_waitcnt vmcnt(5) lgkmcnt(0)
    v_cmp_gt_u32 vcc, 5, v6
    s_cbranch_vccz L_KF12
    buffer_load_dwordx4 v[128:131], v20, s[8:11], s71 offen offset:0 nt
    ds_read_b32 v6, v23 offset:13060
    s_waitcnt vmcnt(5) lgkmcnt(0)
    v_cmp_gt_u32 vcc, 5, v6
    s_cbranch_vccz L_KF13
    buffer_load_dwordx4 v[132:135], v20, s[8:11], s71 offen offset:1024 nt
    ds_read_b32 v6, v23 offset:13060
    s_waitcnt vmcnt(5) lgkmcnt(0)
    v_cmp_gt_u32 vcc, 5, v6
    s_cbranch_vccz L_KF14
    buffer_load_dwordx4 v[136:139], v20, s[8:11], s71 offen offset:2048 nt
    ds_read_b32 v6, v23 offset:13060
    s_waitcnt vmcnt(5) lgkmcnt(0)
    v_cmp_gt_u32 vcc, 5, v6
    s_cbranch_vccz L_KF15
    buffer_load_dwordx4 v[140:143], v20, s[8:11], s71 offen offset:3072 nt
    s_branch L_KF16
L_AUX2:
    s_mov_b32 s26, 0x21c000
    s_mov_b32 s27, 0x20000
    s_lshr_b32 s71, s2, 1
    s_bitcmp1_b32 s2, 0
    s_cselect_b32 s71, 127, s71
    s_and_b32 s49, s71, 7
    s_mul_i32 s51, s49, 20
    s_add_u32 s49, s51, s46
    s_mul_i32 s57, s49, 13824
    s_lshr_b32 s51, s71, 3
    s_lshl_b32 s51, s51, 8
    s_add_u32 s57, s57, s51
    s_cmp_ge_u32 s71, 112
    s_cselect_b32 s57, 0x7ff00000, s57
    v_mul_u32_u24 v35, 3456, v2
    v_add_u32 v35, v35, v27
    s_load_dwordx2 s[28:29], s[0:1], 56
    s_load_dwordx2 s[32:33], s[0:1], 72
    s_load_dwordx2 s[36:37], s[0:1], 80
    s_movk_i32 s30, 3456
    s_mov_b32 s31, 0x20000
    s_movk_i32 s34, 1280
    s_mov_b32 s35, 0x20000
    s_movk_i32 s38, 1280
    s_mov_b32 s39, 0x20000
    s_mov_b32 s23, 0x20000
    s_mul_i32 s50, s52, 80
    v_lshl_add_u32 v21, v2, 2, s50
    s_lshl_b32 s50, s49, 4
    v_lshl_add_u32 v22, v2, 2, s50
    s_sub_u32 s50, s2, 160
    s_mul_i32 s51, s50, 205
    s_lshr_b32 s51, s51, 10
    s_mul_i32 s52, s51, 5
    s_sub_u32 s52, s50, s52
    s_cmp_ge_u32 s2, 230
    s_cselect_b32 s47, 2, 1
    s_cmp_lt_u32 s2, 160
    s_cselect_b32 s47, 0, s47
    s_cselect_b32 s53, s44, s51
    s_cselect_b32 s54, s45, s52
    s_cselect_b32 s50, 32, 64
    s_mov_b32 s22, 2211840
    s_cselect_b32 s22, 5242880, s22
    s_load_dwordx2 s[20:21], s[0:1], s50
    v_and_b32 v7, 1, v3
    v_lshlrev_b32 v7, 4, v7
    v_mov_b32 v8, 0xffff
    v_lshlrev_b32 v7, v7, v8
    v_lshrrev_b32 v8, 1, v3
    v_cmp_eq_u32 s[60:61], 0, v8
    v_cmp_eq_u32 s[62:63], 1, v8
    v_cmp_eq_u32 s[64:65], 2, v8
    v_cmp_eq_u32 s[66:67], 3, v8
    v_lshlrev_b32 v25, 3, v1
    s_and_b32 s51, s46, 3
    s_lshl_b32 s51, s51, 9
    v_lshl_add_u32 v24, v2, 4, s51
    v_lshl_add_u32 v24, v3, 5, v24
    v_cndmask_b32 v16, 0, v7, s[60:61]
    v_cndmask_b32 v17, 0, v7, s[62:63]
    v_cndmask_b32 v18, 0, v7, s[64:65]
    v_cndmask_b32 v19, 0, v7, s[66:67]
    s_waitcnt vmcnt(6)
    v_lshlrev_b32 v36, 16, v30
    v_and_b32 v37, 0xffff0000, v30
    v_lshlrev_b32 v38, 16, v31
    v_and_b32 v39, 0xffff0000, v31
    v_lshlrev_b32 v40, 16, v32
    v_and_b32 v41, 0xffff0000, v32
    v_lshlrev_b32 v42, 16, v33
    v_and_b32 v43, 0xffff0000, v33
    v_lshlrev_b32 v44, 16, v34
    v_and_b32 v45, 0xffff0000, v34
    v_pk_add_f32 v[4:5], v[36:37], v[38:39]
    v_pk_add_f32 v[6:7], v[40:41], v[42:43]
    v_pk_add_f32 v[4:5], v[4:5], v[44:45]
    v_pk_add_f32 v[4:5], v[4:5], v[6:7]
    v_add_f32 v4, v4, v5
    s_nop 1
    v_add_f32_dpp v4, v4, v4 row_ror:8 row_mask:0xf bank_mask:0xf
    s_nop 1
    v_add_f32_dpp v4, v4, v4 row_ror:4 row_mask:0xf bank_mask:0xf
    s_nop 1
    v_add_f32_dpp v4, v4, v4 row_ror:2 row_mask:0xf bank_mask:0xf
    s_nop 1
    v_add_f32_dpp v4, v4, v4 row_ror:1 row_mask:0xf bank_mask:0xf
    s_nop 1
    v_add_f32_dpp v4, v4, v4 row_bcast:15 row_mask:0xa bank_mask:0xf
    s_nop 1
    v_add_f32_dpp v4, v4, v4 row_bcast:31 row_mask:0xc bank_mask:0xf
    s_nop 0
    v_readlane_b32 s51, v4, 63
    v_mov_b32 v5, 0x3acccccd
    s_nop 0
    v_mul_f32 v4, s51, v5
    v_cvt_pk_bf16_f32 v8, v4, v4
    v_and_b32 v8, 0xffff0000, v8
    v_sub_f32 v6, v36, v4
    v_mul_f32 v10, v6, v6
    v_sub_f32 v7, v37, v4
    v_mul_f32 v11, v7, v7
    v_sub_f32 v6, v38, v4
    v_fmac_f32 v10, v6, v6
    v_sub_f32 v7, v39, v4
    v_fmac_f32 v11, v7, v7
    v_sub_f32 v6, v40, v4
    v_fmac_f32 v10, v6, v6
    v_sub_f32 v7, v41, v4
    v_fmac_f32 v11, v7, v7
    v_sub_f32 v6, v42, v4
    v_fmac_f32 v10, v6, v6
    v_sub_f32 v7, v43, v4
    v_fmac_f32 v11, v7, v7
    v_sub_f32 v6, v44, v4
    v_fmac_f32 v10, v6, v6
    v_sub_f32 v7, v45, v4
    v_fmac_f32 v11, v7, v7
    v_add_f32 v4, v10, v11
    s_nop 1
    v_add_f32_dpp v4, v4, v4 row_ror:8 row_mask:0xf bank_mask:0xf
    s_nop 1
    v_add_f32_dpp v4, v4, v4 row_ror:4 row_mask:0xf bank_mask:0xf
    s_nop 1
    v_add_f32_dpp v4, v4, v4 row_ror:2 row_mask:0xf bank_mask:0xf
    s_nop 1
    v_add_f32_dpp v4, v4, v4 row_ror:1 row_mask:0xf bank_mask:0xf
    s_nop 1
    v_add_f32_dpp v4, v4, v4 row_bcast:15 row_mask:0xa bank_mask:0xf
    s_nop 1
    v_add_f32_dpp v4, v4, v4 row_bcast:31 row_mask:0xc bank_mask:0xf
    s_nop 0
    v_readlane_b32 s51, v4, 63
    v_sub_f32 v36, v36, v8
    v_sub_f32 v37, v37, v8
    v_sub_f32 v38, v38, v8
    v_sub_f32 v39, v39, v8
    v_sub_f32 v40, v40, v8
    v_sub_f32 v41, v41, v8
    v_sub_f32 v42, v42, v8
    v_sub_f32 v43, v43, v8
    v_sub_f32 v44, v44, v8
    v_sub_f32 v45, v45, v8
    v_mul_f32 v4, s51, v5
    v_cvt_pk_bf16_f32 v4, v4, v4
    v_and_b32 v4, 0xffff0000, v4
    v_add_f32 v4, 0x3727c5ac, v4
    v_cvt_pk_bf16_f32 v4, v4, v4
    v_and_b32 v4, 0xffff0000, v4
    v_sqrt_f32 v4, v4
    v_cvt_pk_bf16_f32 v30, v36, v37
    v_cvt_pk_bf16_f32 v31, v38, v39
    v_cvt_pk_bf16_f32 v32, v40, v41
    v_cvt_pk_bf16_f32 v33, v42, v43
    v_cvt_pk_bf16_f32 v34, v44, v45
    v_cvt_pk_bf16_f32 v4, v4, v4
    v_and_b32 v4, 0xffff0000, v4
    v_rcp_f32 v4, v4
    v_lshlrev_b32 v36, 16, v30
    v_and_b32 v37, 0xffff0000, v30
    v_lshlrev_b32 v38, 16, v31
    v_and_b32 v39, 0xffff0000, v31
    v_lshlrev_b32 v40, 16, v32
    v_and_b32 v41, 0xffff0000, v32
    v_lshlrev_b32 v42, 16, v33
    v_and_b32 v43, 0xffff0000, v33
    v_lshlrev_b32 v44, 16, v34
    v_and_b32 v45, 0xffff0000, v34
    v_mul_f32 v36, v36, v4
    v_mul_f32 v37, v37, v4
    v_mul_f32 v38, v38, v4
    v_mul_f32 v39, v39, v4
    v_mul_f32 v40, v40, v4
    v_mul_f32 v41, v41, v4
    v_mul_f32 v42, v42, v4
    v_mul_f32 v43, v43, v4
    v_mul_f32 v44, v44, v4
    v_mul_f32 v45, v45, v4
    v_cvt_pk_bf16_f32 v36, v36, v36
    v_cvt_pk_bf16_f32 v37, v37, v37
    v_cvt_pk_bf16_f32 v38, v38, v38
    v_cvt_pk_bf16_f32 v39, v39, v39
    v_cvt_pk_bf16_f32 v40, v40, v40
    v_cvt_pk_bf16_f32 v41, v41, v41
    v_cvt_pk_bf16_f32 v42, v42, v42
    v_cvt_pk_bf16_f32 v43, v43, v43
    v_cvt_pk_bf16_f32 v44, v44, v44
    v_cvt_pk_bf16_f32 v45, v45, v45
    v_lshlrev_b32 v4, 5, v1
    ds_write_b128 v4, v[36:39]
    ds_write_b128 v4, v[40:43] offset:16
    ds_write_b64 v25, v[44:45] offset:2048
    ds_read_b32 v52, v21 offset:0
    ds_read_b32 v53, v21 offset:16
    ds_read_b32 v54, v21 offset:32
    ds_read_b32 v55, v21 offset:48
    ds_read_b32 v56, v21 offset:64
    ds_read_b32 v96, v22 offset:0
    ds_read_b32 v97, v22 offset:64
    ds_read_b32 v98, v22 offset:128
    ds_read_b32 v99, v22 offset:192
    ds_read_b32 v100, v22 offset:256
    v_and_b32 v7, 1, v2
    v_lshlrev_b32 v7, 3, v7
    v_lshrrev_b32 v6, 1, v2
    v_add_u32 v7, v7, v6
    v_mul_u32_u24 v23, 1280, v7
    v_add_u32 v23, v23, v27
    s_lshl_b32 s50, s53, 2
    s_add_u32 s50, s50, s46
    s_mul_i32 s58, s50, 40960
    s_lshl_b32 s50, s54, 8
    s_add_u32 s58, s58, s50
    s_getreg_b32 s65, hwreg(HW_REG_XCC_ID, 0, 4)
    s_add_u32 s65, s65, 1
    s_lshl_b32 s65, s65, 27
    s_lshl_b32 s63, s44, 13
    s_lshl_b32 s51, s45, 10
    s_add_u32 s51, s51, s63
    s_add_u32 s56, s51, 0x50000
    s_add_u32 s52, s56, 0x110000
    s_lshl_b32 s50, s46, 11
    s_add_u32 s63, s63, s50
    s_add_u32 s63, s63, 0x160000
    s_mov_b32 s55, 0x40000
    v_mov_b32 v14, 1
    s_waitcnt lgkmcnt(0)
    v_and_b32 v140, v16, v52
    v_and_b32 v141, v17, v52
    v_and_b32 v142, v18, v52
    v_and_b32 v143, v19, v52
    v_and_b32 v144, v16, v53
    v_and_b32 v145, v17, v53
    v_and_b32 v146, v18, v53
    v_and_b32 v147, v19, v53
    v_and_b32 v148, v16, v54
    v_and_b32 v149, v17, v54
    v_and_b32 v150, v18, v54
    v_and_b32 v151, v19, v54
    v_and_b32 v152, v16, v55
    v_and_b32 v153, v17, v55
    v_and_b32 v154, v18, v55
    v_and_b32 v155, v19, v55
    v_and_b32 v156, v16, v56
    v_and_b32 v157, v17, v56
    v_and_b32 v158, v18, v56
    v_and_b32 v159, v19, v56
    s_waitcnt vmcnt(4)
    v_readfirstlane_b32 s48, v29
    v_mfma_f32_16x16x32_bf16 v[68:71], v[140:143], v[76:79], 0
    s_waitcnt vmcnt(3)
    v_mfma_f32_16x16x32_bf16 v[68:71], v[144:147], v[80:83], v[68:71]
    s_waitcnt vmcnt(2)
    v_mfma_f32_16x16x32_bf16 v[68:71], v[148:151], v[84:87], v[68:71]
    s_waitcnt vmcnt(1)
    v_mfma_f32_16x16x32_bf16 v[68:71], v[152:155], v[88:91], v[68:71]
    s_waitcnt vmcnt(0)
    v_mfma_f32_16x16x32_bf16 v[68:71], v[156:159], v[92:95], v[68:71]
    s_add_u32 s48, s48, 1
    s_xor_b32 s65, s65, s48
    v_mov_b32 v45, s65
    v_mov_b32 v47, s65
    s_mov_b32 exec_hi, 0
    s_nop 2
    ds_write_b128 v24, v[68:71] offset:2560
    s_mov_b64 exec, 1
    ds_add_rtn_u32 v6, v13, v14 offset:13060
    s_mov_b64 exec, -1
    ds_read2st64_b64 v[36:39], v25 offset0:5 offset1:6
    ds_read2st64_b64 v[40:43], v25 offset0:7 offset1:8
    s_waitcnt lgkmcnt(2)
    v_readfirstlane_b32 s50, v6
    s_nop 0
    s_cmp_eq_u32 s50, 3
    s_cbranch_scc0 L_WP
    s_waitcnt lgkmcnt(1)
    v_pk_add_f32 v[36:37], v[36:37], v[38:39]
    s_waitcnt lgkmcnt(0)
    v_pk_add_f32 v[40:41], v[40:41], v[42:43]
    v_add_f32 v44, v36, v40
    v_add_f32 v46, v37, v41
    buffer_store_dwordx4 v[44:47], v26, s[40:43], s52 offen
    s_mov_b64 exec, 1
    ds_add_u32 v13, v14 offset:13060
    s_mov_b64 exec, -1
    s_branch L_QP
L_WP:
    s_sub_u32 s3, s3, 1
    s_cbranch_scc1 L_EXIT
    ds_read_b32 v6, v13 offset:13060
    s_waitcnt lgkmcnt(0)
    v_cmp_gt_u32 vcc, 5, v6
    s_cbranch_vccnz L_WP
L_QP:
    buffer_load_dwordx4 v[192:195], v26, s[40:43], s63 offen sc1
    buffer_load_dwordx4 v[196:199], v26, s[40:43], s63 offen offset:1024 sc1
    buffer_load_dwordx4 v[76:79], v35, s[24:27], s57 offen nt
    s_add_u32 s57, s57, 55296
    buffer_load_dwordx4 v[80:83], v35, s[24:27], s57 offen nt
    s_add_u32 s57, s57, 55296
    buffer_load_dwordx4 v[84:87], v35, s[24:27], s57 offen nt
    s_add_u32 s57, s57, 55296
    buffer_load_dwordx4 v[88:91], v35, s[24:27], s57 offen nt
    s_add_u32 s57, s57, 55296
    buffer_load_dwordx4 v[92:95], v35, s[24:27], s57 offen nt
    s_cmp_lg_u32 s46, 0
    s_cbranch_scc1 L_NOX
    v_mov_b32 v48, s65
    v_mov_b32 v49, s48
    s_lshr_b32 s50, s56, 7
    s_add_u32 s50, s50, 0x600
    s_mov_b64 exec, 1
    buffer_store_dwordx2 v[48:49], v13, s[40:43], s50 offen sc1
    s_mov_b64 exec, -1
L_NOX:
    v_lshrrev_b32 v21, 3, v1
    v_and_b32 v7, 7, v1
    s_lshl_b32 s50, s46, 8
    v_lshl_add_u32 v20, v7, 4, s50
    v_lshl_add_u32 v20, v21, 10, v20
    v_lshlrev_b32 v21, 7, v21
    v_lshrrev_b32 v9, 5, v1
    v_lshl_add_u32 v10, v7, 1, v9
    s_lshl_b32 s50, s53, 7
    s_lshl_b32 s51, s46, 5
    s_add_u32 s50, s50, s51
    v_add_lshl_u32 v101, v10, s50, 1
    v_lshrrev_b32 v22, 2, v1
    v_mul_u32_u24 v22, 3072, v22
    v_and_b32 v7, 3, v1
    v_lshl_add_u32 v22, v7, 4, v22
    s_mul_i32 s62, s54, 49152
    s_lshl_b32 s51, s53, 6
    s_add_u32 s62, s62, s51
    s_add_u32 s62, s62, 0xd0000
    s_lshl_b32 s60, s53, 13
    s_add_u32 s60, s60, 0x120000
    s_lshl_b32 s61, s44, 10
    s_add_u32 s61, s61, 0x118000
    s_cmp_eq_u32 s47, 0
    s_cbranch_scc1 L_C0
    s_add_u32 s60, s60, 0xfff70000
    s_add_u32 s62, s62, 2048
    s_cmp_eq_u32 s47, 1
    s_cbranch_scc1 L_C0
    s_sub_u32 s59, s2, 230
    s_lshl_b32 s59, s59, 2
    s_add_u32 s59, s59, s46
    v_lshl_add_u32 v9, v7, 1, v9
    s_lshl_b32 s50, s59, 3
    v_add_lshl_u32 v23, v9, s50, 1
    s_mul_i32 s60, s59, 3072
    s_add_u32 s60, s60, 0xd0000
    s_branch L_C0
L_QR:
    s_sub_u32 s55, s55, 1
    s_cbranch_scc1 L_EXIT
    s_and_b32 s50, s55, 7
    s_cbranch_scc1 L_QR2
    s_cmp_eq_u32 s65, s48
    s_cbranch_scc1 L_QR2
    s_lshl_b32 s50, s44, 6
    s_lshl_b32 s51, s46, 4
    s_add_u32 s50, s50, s51
    s_add_u32 s50, s50, 0x1000
    buffer_load_dwordx4 v[192:195], v13, s[40:43], s50 offen sc1
    s_waitcnt vmcnt(0)
    v_cmp_eq_u32 s[66:67], s48, v193
    v_cmp_ne_u32 vcc, s65, v192
    s_nop 0
    s_and_b64 s[68:69], s[66:67], vcc
    v_cmp_eq_u32 s[66:67], s48, v195
    v_cmp_ne_u32 vcc, s65, v194
    s_nop 0
    s_and_b64 s[66:67], s[66:67], vcc
    s_or_b64 s[66:67], s[66:67], s[68:69]
    s_cbranch_scc0 L_QR2
    s_sub_u32 s63, s63, 0x110000
    s_mov_b32 s65, s48
    v_mov_b32 v45, s48
    v_mov_b32 v47, s48
    ds_write_b32 v13, v14 offset:13112
    ds_read2st64_b64 v[36:39], v25 offset0:5 offset1:6
    ds_read2st64_b64 v[40:43], v25 offset0:7 offset1:8
    s_waitcnt lgkmcnt(1)
    v_pk_add_f32 v[36:37], v[36:37], v[38:39]
    s_waitcnt lgkmcnt(0)
    v_pk_add_f32 v[40:41], v[40:41], v[42:43]
    v_add_f32 v44, v36, v40
    v_add_f32 v46, v37, v41
    buffer_store_dwordx4 v[44:47], v26, s[40:43], s56 offen sc1
L_QR2:
    buffer_load_dwordx4 v[192:195], v26, s[40:43], s63 offen sc1
    buffer_load_dwordx4 v[196:199], v26, s[40:43], s63 offen offset:1024 sc1
    s_waitcnt vmcnt(0)
L_C0:
    s_cmp_eq_u32 s46, 0
    s_waitcnt vmcnt(6)
    s_cbranch_scc1 L_C1
    s_waitcnt vmcnt(5)
L_C1:
    v_xor_b32 v4, s65, v193
    v_xor_b32 v5, s65, v195
    v_xor_b32 v6, s65, v197
    v_xor_b32 v7, s65, v199
    v_or3_b32 v4, v4, v5, v6
    v_or_b32 v7, v7, v4
    v_cmp_ne_u32 vcc, 0, v7
    s_cbranch_vccnz L_QR
    v_add_f32 v192, v192, v196
    v_add_f32 v193, v194, v198
    s_lshl_b32 s51, s46, 9
    v_add_u32 v4, s51, v25
    s_mov_b32 s55, 0x40000
    ds_write_b64 v4, v[192:193] offset:6656
    s_mov_b64 exec, 1
    ds_add_rtn_u32 v6, v13, v14 offset:13068
    s_mov_b64 exec, -1
    ds_read2st64_b64 v[36:39], v25 offset0:13 offset1:14
    ds_read2st64_b64 v[40:43], v25 offset0:15 offset1:16
    s_waitcnt lgkmcnt(2)
    v_readfirstlane_b32 s50, v6
    s_nop 0
    s_cmp_eq_u32 s50, 3
    s_cbranch_scc0 L_QD
    s_waitcnt lgkmcnt(1)
    v_pk_add_f32 v[36:37], v[36:37], v[38:39]
    s_waitcnt lgkmcnt(0)
    v_pk_add_f32 v[40:41], v[40:41], v[42:43]
    v_add_f32 v44, v36, v40
    v_add_f32 v46, v37, v41
    v_cvt_pk_bf16_f32 v36, v44, v46
    v_lshlrev_b32 v4, 2, v1
    ds_read_b32 v5, v13 offset:13112
    ds_write_b32 v4, v36 offset:12800
    v_mov_b32 v6, s65
    v_mov_b32 v7, s48
    s_waitcnt lgkmcnt(0)
    v_cmp_ne_u32 vcc, 0, v5
    s_nop 1
    v_cndmask_b32 v6, v6, v7, vcc
    ds_write_b32 v13, v6 offset:13088
    ds_write_b32 v13, v14 offset:13108
L_QD:
    v_mov_b32 v45, s48
    v_mov_b32 v47, s48
    v_and_b32 v60, v16, v96
    v_and_b32 v61, v17, v96
    v_and_b32 v62, v18, v96
    v_and_b32 v63, v19, v96
    s_waitcnt vmcnt(0) lgkmcnt(0)
    v_and_b32 v64, v16, v97
    v_and_b32 v65, v17, v97
    v_and_b32 v66, v18, v97
    v_and_b32 v67, v19, v97
    v_mfma_f32_16x16x32_bf16 v[72:75], v[60:63], v[76:79], 0
    v_and_b32 v60, v16, v98
    v_and_b32 v61, v17, v98
    v_and_b32 v62, v18, v98
    v_and_b32 v63, v19, v98
    v_mfma_f32_16x16x32_bf16 v[72:75], v[64:67], v[80:83], v[72:75]
    v_and_b32 v64, v16, v99
    v_and_b32 v65, v17, v99
    v_and_b32 v66, v18, v99
    v_and_b32 v67, v19, v99
    v_mfma_f32_16x16x32_bf16 v[72:75], v[60:63], v[84:87], v[72:75]
    v_and_b32 v60, v16, v100
    v_and_b32 v61, v17, v100
    v_and_b32 v62, v18, v100
    v_and_b32 v63, v19, v100
    v_mfma_f32_16x16x32_bf16 v[72:75], v[64:67], v[88:91], v[72:75]
    s_nop 1
    v_mfma_f32_16x16x32_bf16 v[72:75], v[60:63], v[92:95], v[72:75]
    s_lshl_b32 s51, s71, 10
    s_add_u32 s51, s51, 0x90000
    s_mov_b32 exec_hi, 0
    s_nop 4
    ds_write_b128 v24, v[72:75] offset:4608
    s_mov_b64 exec, 1
    ds_add_rtn_u32 v6, v13, v14 offset:13092
    s_mov_b64 exec, -1
    ds_read2st64_b64 v[36:39], v25 offset0:9 offset1:10
    ds_read2st64_b64 v[40:43], v25 offset0:11 offset1:12
    s_waitcnt lgkmcnt(2)
    v_readfirstlane_b32 s50, v6
    s_nop 0
    s_cmp_eq_u32 s50, 3
    s_cbranch_scc0 L_HD
    s_waitcnt lgkmcnt(1)
    v_pk_add_f32 v[36:37], v[36:37], v[38:39]
    s_waitcnt lgkmcnt(0)
    v_pk_add_f32 v[40:41], v[40:41], v[42:43]
    v_add_f32 v44, v36, v40
    v_add_f32 v46, v37, v41
    s_cmp_ge_u32 s71, 112
    s_cbranch_scc1 L_HD
    buffer_store_dwordx4 v[44:47], v26, s[40:43], s51 offen sc1
L_HD:
    s_setprio 0
    s_cmp_eq_u32 s47, 2
    s_cbranch_scc1 L_FIN
    buffer_load_short_d16_hi v28, v101, s[28:31], 0 offen
    buffer_load_short_d16_hi v29, v101, s[28:31], 0 offen offset:32
    buffer_load_dwordx4 v[108:111], v23, s[20:23], s58 offen offset:0 nt
    buffer_load_dwordx4 v[112:115], v23, s[20:23], s58 offen offset:2560 nt
    s_add_u32 s58, s58, 5120
    buffer_load_dwordx4 v[116:119], v23, s[20:23], s58 offen offset:0 nt
    buffer_load_dwordx4 v[120:123], v23, s[20:23], s58 offen offset:2560 nt
    s_add_u32 s58, s58, 15360
    buffer_load_dwordx4 v[124:127], v23, s[20:23], s58 offen offset:0 nt
    buffer_load_dwordx4 v[128:131], v23, s[20:23], s58 offen offset:2560 nt
    s_add_u32 s58, s58, 5120
    buffer_load_dwordx4 v[132:135], v23, s[20:23], s58 offen offset:0 nt
    buffer_load_dwordx4 v[136:139], v23, s[20:23], s58 offen offset:2560 nt
    s_cmp_eq_u32 s47, 1
    s_cbranch_scc1 L_POLL1
L_UW:
    s_sub_u32 s3, s3, 1
    s_cbranch_scc1 L_EXIT
    ds_read_b32 v6, v13 offset:13100
    ds_read_b32 v7, v13 offset:13112
    s_waitcnt lgkmcnt(0)
    v_cmp_gt_u32 vcc, 4, v6
    s_cbranch_vccnz L_UW
    v_readfirstlane_b32 s50, v7
    s_nop 0
    s_cmp_eq_u32 s50, 0
    s_cbranch_scc1 L_MR
    s_mov_b32 s65, s48
    s_sub_u32 s60, s60, 0x110000
    s_sub_u32 s61, s61, 0x110000
L_MR:
    s_sub_u32 s55, s55, 1
    s_cbranch_scc1 L_EXIT
    buffer_load_dwordx4 v[180:183], v21, s[40:43], s61 offen sc1
    buffer_load_dwordx4 v[172:175], v20, s[40:43], s60 offen sc1
    buffer_load_dwordx4 v[176:179], v20, s[40:43], s60 offen offset:128 sc1
    s_waitcnt vmcnt(2)
    v_xor_b32 v4, s65, v181
    v_xor_b32 v5, s65, v183
    v_or_b32 v4, v4, v5
    v_cmp_ne_u32 vcc, 0, v4
    s_cbranch_vccnz L_MR
    buffer_load_dwordx4 v[192:195], v20, s[40:43], s60 offen sc1
    buffer_load_dwordx4 v[196:199], v20, s[40:43], s60 offen offset:128 sc1
    v_mov_b32 v4, v180
    s_nop 1
    v_max_f32_dpp v4, v4, v4 row_ror:8 row_mask:0xf bank_mask:0xf
    v_mov_b32 v5, v4
    s_nop 1
    v_permlane16_swap_b32 v4, v5
    v_max_f32 v4, v4, v5
    v_mov_b32 v5, v4
    s_nop 1
    v_permlane32_swap_b32 v4, v5
    v_max_f32 v4, v4, v5
    v_sub_f32 v4, v180, v4
    v_mul_f32 v4, 0x3fb8aa3b, v4
    v_exp_f32 v188, v4
    s_nop 0
    v_mul_f32 v6, v188, v182
    s_nop 1
    v_add_f32_dpp v6, v6, v6 row_ror:8 row_mask:0xf bank_mask:0xf
    v_mov_b32 v5, v6
    s_nop 1
    v_permlane16_swap_b32 v6, v5
    v_add_f32 v6, v6, v5
    v_mov_b32 v5, v6
    s_nop 1
    v_permlane32_swap_b32 v6, v5
    v_add_f32 v6, v6, v5
    v_rcp_f32 v6, v6
    s_nop 0
    v_mul_f32 v188, v188, v6
    s_waitcnt vmcnt(2)
    v_xor_b32 v4, s65, v173
    v_xor_b32 v5, s65, v175
    v_xor_b32 v6, s65, v177
    v_xor_b32 v7, s65, v179
    v_or3_b32 v4, v4, v5, v6
    v_or_b32 v7, v7, v4
    v_cmp_ne_u32 vcc, 0, v7
    s_cbranch_vccz L_OG
    s_waitcnt vmcnt(0)
    v_xor_b32 v4, s65, v193
    v_xor_b32 v5, s65, v195
    v_xor_b32 v6, s65, v197
    v_xor_b32 v7, s65, v199
    v_or3_b32 v4, v4, v5, v6
    v_or_b32 v7, v7, v4
    v_cmp_ne_u32 vcc, 0, v7
    s_cbranch_vccnz L_OR
    v_mul_f32 v172, v192, v188
    v_mul_f32 v174, v194, v188
    v_mul_f32 v176, v196, v188
    v_mul_f32 v178, v198, v188
    s_branch L_OH
L_OR:
    s_sub_u32 s55, s55, 1
    s_cbranch_scc1 L_EXIT
    buffer_load_dwordx4 v[172:175], v20, s[40:43], s60 offen sc1
    buffer_load_dwordx4 v[176:179], v20, s[40:43], s60 offen offset:128 sc1
L_OC:
    s_waitcnt vmcnt(0)
    v_xor_b32 v4, s65, v173
    v_xor_b32 v5, s65, v175
    v_xor_b32 v6, s65, v177
    v_xor_b32 v7, s65, v179
    v_or3_b32 v4, v4, v5, v6
    v_or_b32 v7, v7, v4
    v_cmp_ne_u32 vcc, 0, v7
    s_cbranch_vccnz L_OR
L_OG:
    v_mul_f32 v172, v172, v188
    v_mul_f32 v174, v174, v188
    v_mul_f32 v176, v176, v188
    v_mul_f32 v178, v178, v188
L_OH:
    s_nop 0
    v_permlane32_swap_b32 v172, v174
    v_permlane32_swap_b32 v176, v178
    v_add_f32 v172, v172, v174
    v_add_f32 v176, v176, v178
    v_mov_b32 v174, v172
    v_mov_b32 v178, v176
    s_nop 0
    v_permlane16_swap_b32 v172, v174
    v_permlane16_swap_b32 v176, v178
    v_add_f32 v172, v172, v174
    v_add_f32 v176, v176, v178
    s_nop 0
    v_add_f32_dpp v172, v172, v172 row_ror:8 row_mask:0xf bank_mask:0xf
    v_add_f32_dpp v176, v176, v176 row_ror:8 row_mask:0xf bank_mask:0xf
L_GEMV2:
    v_cvt_pk_bf16_f32 v172, v172, v172
    v_cvt_pk_bf16_f32 v176, v176, v176
    s_nop 0
    v_mov_b32_dpp v172, v172 row_ror:4 row_mask:0xa bank_mask:0xf
    v_mov_b32_dpp v176, v176 row_ror:4 row_mask:0xa bank_mask:0xf
    s_nop 0
    v_and_b32_dpp v140, v172, v16 row_newbcast:0 row_mask:0xf bank_mask:0xf
    v_and_b32_dpp v141, v172, v17 row_newbcast:0 row_mask:0xf bank_mask:0xf
    v_and_b32_dpp v142, v172, v18 row_newbcast:0 row_mask:0xf bank_mask:0xf
    v_and_b32_dpp v143, v172, v19 row_newbcast:0 row_mask:0xf bank_mask:0xf
    v_and_b32_dpp v144, v172, v16 row_newbcast:1 row_mask:0xf bank_mask:0xf
    v_and_b32_dpp v145, v172, v17 row_newbcast:1 row_mask:0xf bank_mask:0xf
    v_and_b32_dpp v146, v172, v18 row_newbcast:1 row_mask:0xf bank_mask:0xf
    v_and_b32_dpp v147, v172, v19 row_newbcast:1 row_mask:0xf bank_mask:0xf
    v_mfma_f32_16x16x32_bf16 v[68:71], v[140:143], v[108:111], 0
    v_and_b32_dpp v148, v172, v16 row_newbcast:2 row_mask:0xf bank_mask:0xf
    v_and_b32_dpp v149, v172, v17 row_newbcast:2 row_mask:0xf bank_mask:0xf
    v_and_b32_dpp v150, v172, v18 row_newbcast:2 row_mask:0xf bank_mask:0xf
    v_and_b32_dpp v151, v172, v19 row_newbcast:2 row_mask:0xf bank_mask:0xf
    v_mfma_f32_16x16x32_bf16 v[68:71], v[144:147], v[112:115], v[68:71]
    v_and_b32_dpp v152, v172, v16 row_newbcast:3 row_mask:0xf bank_mask:0xf
    v_and_b32_dpp v153, v172, v17 row_newbcast:3 row_mask:0xf bank_mask:0xf
    v_and_b32_dpp v154, v172, v18 row_newbcast:3 row_mask:0xf bank_mask:0xf
    v_and_b32_dpp v155, v172, v19 row_newbcast:3 row_mask:0xf bank_mask:0xf
    v_mfma_f32_16x16x32_bf16 v[68:71], v[148:151], v[116:119], v[68:71]
    v_and_b32_dpp v156, v176, v16 row_newbcast:0 row_mask:0xf bank_mask:0xf
    v_and_b32_dpp v157, v176, v17 row_newbcast:0 row_mask:0xf bank_mask:0xf
    v_and_b32_dpp v158, v176, v18 row_newbcast:0 row_mask:0xf bank_mask:0xf
    v_and_b32_dpp v159, v176, v19 row_newbcast:0 row_mask:0xf bank_mask:0xf
    v_mfma_f32_16x16x32_bf16 v[68:71], v[152:155], v[120:123], v[68:71]
    v_and_b32_dpp v160, v176, v16 row_newbcast:1 row_mask:0xf bank_mask:0xf
    v_and_b32_dpp v161, v176, v17 row_newbcast:1 row_mask:0xf bank_mask:0xf
    v_and_b32_dpp v162, v176, v18 row_newbcast:1 row_mask:0xf bank_mask:0xf
    v_and_b32_dpp v163, v176, v19 row_newbcast:1 row_mask:0xf bank_mask:0xf
    v_mfma_f32_16x16x32_bf16 v[68:71], v[156:159], v[124:127], v[68:71]
    v_and_b32_dpp v164, v176, v16 row_newbcast:2 row_mask:0xf bank_mask:0xf
    v_and_b32_dpp v165, v176, v17 row_newbcast:2 row_mask:0xf bank_mask:0xf
    v_and_b32_dpp v166, v176, v18 row_newbcast:2 row_mask:0xf bank_mask:0xf
    v_and_b32_dpp v167, v176, v19 row_newbcast:2 row_mask:0xf bank_mask:0xf
    v_mfma_f32_16x16x32_bf16 v[68:71], v[160:163], v[128:131], v[68:71]
    v_and_b32_dpp v168, v176, v16 row_newbcast:3 row_mask:0xf bank_mask:0xf
    v_and_b32_dpp v169, v176, v17 row_newbcast:3 row_mask:0xf bank_mask:0xf
    v_and_b32_dpp v170, v176, v18 row_newbcast:3 row_mask:0xf bank_mask:0xf
    v_and_b32_dpp v171, v176, v19 row_newbcast:3 row_mask:0xf bank_mask:0xf
    v_mfma_f32_16x16x32_bf16 v[68:71], v[164:167], v[132:135], v[68:71]
    s_nop 1
    v_mfma_f32_16x16x32_bf16 v[68:71], v[168:171], v[136:139], v[68:71]
    s_mov_b32 exec_hi, 0
    s_nop 6
    ds_write_b128 v24, v[68:71] offset:10752
    s_mov_b64 exec, 1
    ds_add_rtn_u32 v6, v13, v14 offset:13104
    s_mov_b64 exec, -1
    ds_read2st64_b64 v[36:39], v25 offset0:21 offset1:22
    ds_read2st64_b64 v[40:43], v25 offset0:23 offset1:24
    s_waitcnt lgkmcnt(2)
    v_readfirstlane_b32 s50, v6
    s_nop 0
    s_cmp_eq_u32 s50, 3
    s_cbranch_scc0 L_EXIT
    s_waitcnt lgkmcnt(1)
    v_pk_add_f32 v[36:37], v[36:37], v[38:39]
    s_waitcnt lgkmcnt(0)
    v_pk_add_f32 v[40:41], v[40:41], v[42:43]
    v_add_f32 v44, v36, v40
    v_add_f32 v46, v37, v41
    buffer_store_dwordx4 v[44:47], v22, s[40:43], s62 offen sc1
    s_branch L_EXIT
L_POLL1:
    s_sub_u32 s55, s55, 1
    s_cbranch_scc1 L_EXIT
    buffer_load_dwordx4 v[172:175], v20, s[40:43], s60 offen sc1
    buffer_load_dwordx4 v[176:179], v20, s[40:43], s60 offen offset:128 sc1
    s_waitcnt vmcnt(0)
    v_xor_b32 v4, s48, v173
    v_xor_b32 v5, s48, v175
    v_xor_b32 v6, s48, v177
    v_xor_b32 v7, s48, v179
    v_or3_b32 v4, v4, v5, v6
    v_or_b32 v7, v7, v4
    v_cmp_ne_u32 vcc, 0, v7
    s_cbranch_vccnz L_POLL1
    s_nop 0
    v_permlane32_swap_b32 v172, v174
    v_permlane32_swap_b32 v176, v178
    v_add_f32 v172, v172, v174
    v_add_f32 v176, v176, v178
    v_mov_b32 v174, v172
    v_mov_b32 v178, v176
    s_nop 0
    v_permlane16_swap_b32 v172, v174
    v_permlane16_swap_b32 v176, v178
    v_add_f32 v172, v172, v174
    v_add_f32 v176, v176, v178
    s_nop 0
    v_add_f32_dpp v172, v172, v172 row_ror:8 row_mask:0xf bank_mask:0xf
    v_add_f32_dpp v176, v176, v176 row_ror:8 row_mask:0xf bank_mask:0xf
    v_cvt_pk_bf16_f32 v172, v172, v172
    v_and_b32 v172, 0xffff0000, v172
    v_and_b32 v4, 0xffff0000, v28
    v_add_f32 v172, v172, v4
    v_cvt_pk_bf16_f32 v172, v172, v172
    v_and_b32 v172, 0xffff0000, v172
    v_mul_f32 v4, v172, v172
    v_mov_b32 v5, 0xc0135761
    v_fmac_f32 v5, 0xbdd2d3e8, v4
    v_mul_f32 v4, v5, v172
    v_exp_f32 v4, v4
    s_nop 0
    v_add_f32 v4, 1.0, v4
    v_rcp_f32 v4, v4
    s_nop 0
    v_mul_f32 v172, v172, v4
    v_cvt_pk_bf16_f32 v176, v176, v176
    v_and_b32 v176, 0xffff0000, v176
    v_and_b32 v6, 0xffff0000, v29
    v_add_f32 v176, v176, v6
    v_cvt_pk_bf16_f32 v176, v176, v176
    v_and_b32 v176, 0xffff0000, v176
    v_mul_f32 v6, v176, v176
    v_mov_b32 v7, 0xc0135761
    v_fmac_f32 v7, 0xbdd2d3e8, v6
    v_mul_f32 v6, v7, v176
    v_exp_f32 v6, v6
    s_nop 0
    v_add_f32 v6, 1.0, v6
    v_rcp_f32 v6, v6
    s_nop 0
    v_mul_f32 v176, v176, v6
    s_lshl_b32 s50, s53, 2
    s_add_u32 s50, s50, s46
    s_cmp_lt_u32 s50, 54
    s_cbranch_scc1 L_GEMV2
    v_mov_b32 v172, 0
    v_mov_b32 v176, 0
    s_branch L_GEMV2
L_FIN:
    s_cmp_ge_u32 s59, 80
    s_cbranch_scc1 L_EXIT
    buffer_load_ushort v208, v23, s[36:39], 0 offen
    s_mov_b32 exec_lo, 0x0000ffff
    s_mov_b32 exec_hi, 0x0000ffff
    buffer_load_short_d16_hi v28, v23, s[4:7], 0 offen
    s_not_b64 exec, exec
    buffer_load_short_d16_hi v28, v23, s[32:35], 0 offen
    s_mov_b64 exec, -1
    v_mov_b32 v180, 0
    v_mov_b32 v181, s48
    v_mov_b32 v182, 0
    v_mov_b32 v183, s48
L_POLL2:
    s_sub_u32 s55, s55, 1
    s_cbranch_scc1 L_EXIT
    buffer_load_dwordx4 v[172:175], v26, s[40:43], s60 offen sc1
    buffer_load_dwordx4 v[176:179], v26, s[40:43], s60 offen offset:1024 sc1
    s_mov_b32 exec_hi, 0x00ffffff
    buffer_load_dwordx4 v[180:183], v26, s[40:43], s60 offen offset:2048 sc1
    s_mov_b32 exec_hi, -1
    s_waitcnt vmcnt(0)
    v_xor_b32 v4, s48, v173
    v_xor_b32 v5, s48, v175
    v_xor_b32 v6, s48, v177
    v_xor_b32 v7, s48, v179
    v_xor_b32 v8, s48, v181
    v_xor_b32 v9, s48, v183
    v_or3_b32 v4, v4, v5, v6
    v_or3_b32 v7, v7, v8, v9
    v_or_b32 v4, v4, v7
    v_cmp_ne_u32 vcc, 0, v4
    s_cbranch_vccnz L_POLL2
    v_add_f32 v172, v172, v176
    v_add_f32 v174, v174, v178
    v_permlane32_swap_b32 v180, v182
    v_add_f32 v180, v180, v182
    v_permlane32_swap_b32 v172, v174
    v_add_f32 v172, v172, v174
    v_and_b32 v6, 0xffff0000, v28
    s_nop 0
    v_permlane16_swap_b32 v172, v180
    v_add_f32 v172, v172, v180
    s_nop 1
    v_add_f32_dpp v172, v172, v172 row_ror:4 row_mask:0xf bank_mask:0xf
    s_nop 1
    v_add_f32_dpp v172, v172, v172 row_ror:8 row_mask:0xf bank_mask:0xf
    v_cvt_pk_bf16_f32 v172, v172, v172
    v_and_b32 v172, 0xffff0000, v172
    v_add_f32 v172, v172, v6
    v_cvt_pk_bf16_f32 v172, v172, v172
    v_and_b32 v172, 0xffff0000, v172
    v_mov_b32 v5, v172
    s_nop 1
    v_permlane16_swap_b32 v172, v5
    v_add_f32 v172, v172, v5
    v_cvt_pk_bf16_f32 v172, v172, v172
    s_mov_b32 exec_lo, 0xf
    s_mov_b32 exec_hi, 0xf
    buffer_store_short v172, v23, s[36:39], 0 offen
    s_cmp_lg_u32 s59, 0
    s_cbranch_scc1 L_EXIT
    s_mov_b64 exec, 1
    buffer_store_dword v45, v13, s[40:43], 0 offen offset:0
    s_branch L_EXIT
L_KV2:
    v_and_b32 v7, 1, v3
    v_lshlrev_b32 v7, 4, v7
    v_mov_b32 v8, 0xffff
    v_lshlrev_b32 v7, v7, v8
    v_lshrrev_b32 v8, 1, v3
    v_cmp_eq_u32 s[60:61], 0, v8
    v_cmp_eq_u32 s[62:63], 1, v8
    v_cmp_eq_u32 s[64:65], 2, v8
    v_cmp_eq_u32 s[66:67], 3, v8
    v_lshlrev_b32 v25, 3, v1
    s_and_b32 s51, s46, 3
    s_lshl_b32 s51, s51, 9
    v_lshl_add_u32 v24, v2, 4, s51
    v_lshl_add_u32 v24, v3, 5, v24
    v_cndmask_b32 v16, 0, v7, s[60:61]
    v_cndmask_b32 v17, 0, v7, s[62:63]
    v_cndmask_b32 v18, 0, v7, s[64:65]
    v_cndmask_b32 v19, 0, v7, s[66:67]
    v_mov_b32 v36, 0
    v_mov_b32 v37, 0
    v_mov_b32 v38, 0
    v_mov_b32 v39, 0
    v_mov_b32 v40, 0
    v_mov_b32 v41, 0
    v_mov_b32 v42, 0
    v_mov_b32 v43, 0
    v_mov_b32 v44, 0
    v_mov_b32 v45, 0
    v_mov_b32 v46, 0
    v_mov_b32 v47, 0
    v_mov_b32 v48, 0
    v_mov_b32 v49, 0
    v_mov_b32 v50, 0
    v_mov_b32 v51, 0
    s_lshl_b32 s51, s44, 3
    s_add_u32 s51, s51, s45
    s_lshl_b32 s56, s51, 10
    s_add_u32 s56, s56, 0x10000
    s_add_u32 s57, s56, 0x110000
    s_lshl_b32 s58, s51, 7
    s_add_u32 s58, s58, 0x8000
    s_add_u32 s59, s58, 0x110000
    v_mov_b32 v27, 1
L_QW:
    s_sub_u32 s3, s3, 1
    s_cbranch_scc1 L_EXIT
    ds_read_b32 v6, v23 offset:13108
    s_waitcnt lgkmcnt(0)
    v_cmp_gt_u32 vcc, 1, v6
    s_cbranch_vccnz L_QW
    s_mov_b32 exec_lo, 0x000f000f
    s_mov_b32 exec_hi, exec_lo
    ds_read_b128 v[36:39], v22 offset:12800
    s_mov_b32 exec_lo, 0x00f000f0
    s_mov_b32 exec_hi, exec_lo
    ds_read_b128 v[40:43], v22 offset:12800
    s_mov_b32 exec_lo, 0x0f000f00
    s_mov_b32 exec_hi, exec_lo
    ds_read_b128 v[44:47], v22 offset:12800
    s_mov_b32 exec_lo, 0xf000f000
    s_mov_b32 exec_hi, exec_lo
    ds_read_b128 v[48:51], v22 offset:12800
    s_mov_b64 exec, -1
    ds_read_b32 v29, v23 offset:13088
    ds_read_b32 v28, v23 offset:13112
    s_waitcnt vmcnt(16) lgkmcnt(2)
    v_mfma_f32_16x16x32_bf16 v[60:63], v[36:39], v[80:83], 0
    v_mfma_f32_16x16x32_bf16 v[60:63], v[40:43], v[84:87], v[60:63]
    v_mfma_f32_16x16x32_bf16 v[60:63], v[44:47], v[88:91], v[60:63]
    v_mfma_f32_16x16x32_bf16 v[60:63], v[48:51], v[92:95], v[60:63]
    v_mfma_f32_16x16x32_bf16 v[64:67], v[36:39], v[96:99], 0
    v_mfma_f32_16x16x32_bf16 v[64:67], v[40:43], v[100:103], v[64:67]
    v_mfma_f32_16x16x32_bf16 v[64:67], v[44:47], v[104:107], v[64:67]
    v_mfma_f32_16x16x32_bf16 v[64:67], v[48:51], v[108:111], v[64:67]
    v_mfma_f32_16x16x32_bf16 v[68:71], v[36:39], v[112:115], 0
    v_mfma_f32_16x16x32_bf16 v[68:71], v[40:43], v[116:119], v[68:71]
    v_mfma_f32_16x16x32_bf16 v[68:71], v[44:47], v[120:123], v[68:71]
    v_mfma_f32_16x16x32_bf16 v[68:71], v[48:51], v[124:127], v[68:71]
    v_mfma_f32_16x16x32_bf16 v[72:75], v[36:39], v[128:131], 0
    v_mfma_f32_16x16x32_bf16 v[72:75], v[40:43], v[132:135], v[72:75]
    v_mfma_f32_16x16x32_bf16 v[72:75], v[44:47], v[136:139], v[72:75]
    v_mfma_f32_16x16x32_bf16 v[72:75], v[48:51], v[140:143], v[72:75]
    v_mov_b32_dpp v12, v60 quad_perm:[0,0,0,0] row_mask:0xf bank_mask:0xf
    v_mov_b32_dpp v13, v64 quad_perm:[0,0,0,0] row_mask:0xf bank_mask:0xf
    s_nop 1
    v_mov_b32_dpp v14, v68 quad_perm:[0,0,0,0] row_mask:0xf bank_mask:0xf
    s_nop 2
    v_mov_b32_dpp v15, v72 quad_perm:[0,0,0,0] row_mask:0xf bank_mask:0xf
    v_add_f32_dpp v12, v61, v12 quad_perm:[1,1,1,1] row_mask:0xf bank_mask:0xf
    v_add_f32_dpp v13, v65, v13 quad_perm:[1,1,1,1] row_mask:0xf bank_mask:0xf
    v_add_f32_dpp v14, v69, v14 quad_perm:[1,1,1,1] row_mask:0xf bank_mask:0xf
    v_add_f32_dpp v15, v73, v15 quad_perm:[1,1,1,1] row_mask:0xf bank_mask:0xf
    v_add_f32_dpp v12, v62, v12 quad_perm:[2,2,2,2] row_mask:0xf bank_mask:0xf
    v_add_f32_dpp v13, v66, v13 quad_perm:[2,2,2,2] row_mask:0xf bank_mask:0xf
    v_add_f32_dpp v14, v70, v14 quad_perm:[2,2,2,2] row_mask:0xf bank_mask:0xf
    v_add_f32_dpp v15, v74, v15 quad_perm:[2,2,2,2] row_mask:0xf bank_mask:0xf
    v_add_f32_dpp v12, v63, v12 quad_perm:[3,3,3,3] row_mask:0xf bank_mask:0xf
    v_add_f32_dpp v13, v67, v13 quad_perm:[3,3,3,3] row_mask:0xf bank_mask:0xf
    v_add_f32_dpp v14, v71, v14 quad_perm:[3,3,3,3] row_mask:0xf bank_mask:0xf
    v_add_f32_dpp v15, v75, v15 quad_perm:[3,3,3,3] row_mask:0xf bank_mask:0xf
    v_cvt_pk_bf16_f32 v4, v12, v13
    v_cvt_pk_bf16_f32 v5, v14, v15
    v_lshlrev_b32 v12, 16, v4
    v_and_b32 v13, 0xffff0000, v4
    v_lshlrev_b32 v14, 16, v5
    v_and_b32 v15, 0xffff0000, v5
    v_mul_f32 v12, 0x3db504f3, v12
    v_mul_f32 v13, 0x3db504f3, v13
    v_mul_f32 v14, 0x3db504f3, v14
    v_mul_f32 v15, 0x3db504f3, v15
    v_cvt_pk_bf16_f32 v4, v12, v13
    v_cvt_pk_bf16_f32 v5, v14, v15
    v_lshlrev_b32 v12, 16, v4
    v_and_b32 v13, 0xffff0000, v4
    v_lshlrev_b32 v14, 16, v5
    v_and_b32 v15, 0xffff0000, v5
    v_max_f32 v6, v12, v13
    v_max3_f32 v6, v14, v15, v6
    s_mov_b32 exec_lo, 0x11111111
    s_mov_b32 exec_hi, exec_lo
    ds_max_f32 v23, v6 offset:13056
    s_mov_b64 exec, 1
    ds_add_u32 v23, v27 offset:13096
    s_mov_b64 exec, -1
    s_waitcnt lgkmcnt(2)
    v_mov_b32 v45, v29
    v_mov_b32 v47, v29
    v_mov_b32 v49, v29
    v_mov_b32 v51, v29
    v_readfirstlane_b32 s47, v28
L_MW:
    s_sub_u32 s3, s3, 1
    s_cbranch_scc1 L_EXIT
    ds_read_b32 v6, v23 offset:13096
    ds_read_b32 v48, v23 offset:13056
    s_waitcnt lgkmcnt(0)
    v_cmp_gt_u32 vcc, 4, v6
    s_cbranch_vccnz L_MW
    v_sub_f32 v12, v12, v48
    v_sub_f32 v13, v13, v48
    v_sub_f32 v14, v14, v48
    v_sub_f32 v15, v15, v48
    v_mul_f32 v12, 0x3fb8aa3b, v12
    v_mul_f32 v13, 0x3fb8aa3b, v13
    v_mul_f32 v14, 0x3fb8aa3b, v14
    v_mul_f32 v15, 0x3fb8aa3b, v15
    v_exp_f32 v12, v12
    v_exp_f32 v13, v13
    v_exp_f32 v14, v14
    v_exp_f32 v15, v15
    v_add_f32 v6, v12, v13
    v_add_f32 v5, v14, v15
    v_cvt_pk_bf16_f32 v12, v12, v12
    v_cvt_pk_bf16_f32 v13, v13, v13
    v_cvt_pk_bf16_f32 v14, v14, v14
    v_cvt_pk_bf16_f32 v15, v15, v15
    v_add_f32 v6, v6, v5
    v_and_b32_dpp v80, v12, v16 row_newbcast:0 row_mask:0xf bank_mask:0xf
    v_and_b32_dpp v81, v12, v17 row_newbcast:0 row_mask:0xf bank_mask:0xf
    v_add_f32_dpp v6, v6, v6 row_ror:4 row_mask:0xf bank_mask:0xf
    v_and_b32_dpp v82, v12, v18 row_newbcast:0 row_mask:0xf bank_mask:0xf
    v_and_b32_dpp v83, v12, v19 row_newbcast:0 row_mask:0xf bank_mask:0xf
    v_add_f32_dpp v6, v6, v6 row_ror:8 row_mask:0xf bank_mask:0xf
    v_and_b32_dpp v84, v12, v16 row_newbcast:4 row_mask:0xf bank_mask:0xf
    v_and_b32_dpp v85, v12, v17 row_newbcast:4 row_mask:0xf bank_mask:0xf
    v_add_f32_dpp v6, v6, v6 row_bcast:15 row_mask:0xa bank_mask:0xf
    v_and_b32_dpp v86, v12, v18 row_newbcast:4 row_mask:0xf bank_mask:0xf
    v_and_b32_dpp v87, v12, v19 row_newbcast:4 row_mask:0xf bank_mask:0xf
    v_add_f32_dpp v6, v6, v6 row_bcast:31 row_mask:0xc bank_mask:0xf
    v_and_b32_dpp v88, v12, v16 row_newbcast:8 row_mask:0xf bank_mask:0xf
    v_and_b32_dpp v89, v12, v17 row_newbcast:8 row_mask:0xf bank_mask:0xf
    s_lshl_b32 s50, s46, 2
    v_mov_b32 v7, s50
    s_mov_b32 exec_lo, 0
    s_mov_b32 exec_hi, 0x80000000
    ds_write_b32 v7, v6 offset:13056
    ds_add_rtn_u32 v4, v23, v27 offset:13064
    s_mov_b64 exec, -1
    ds_read_b128 v[36:39], v23 offset:13072
    v_and_b32_dpp v90, v12, v18 row_newbcast:8 row_mask:0xf bank_mask:0xf
    v_and_b32_dpp v91, v12, v19 row_newbcast:8 row_mask:0xf bank_mask:0xf
    v_and_b32_dpp v92, v12, v16 row_newbcast:12 row_mask:0xf bank_mask:0xf
    v_and_b32_dpp v93, v12, v17 row_newbcast:12 row_mask:0xf bank_mask:0xf
    v_and_b32_dpp v94, v12, v18 row_newbcast:12 row_mask:0xf bank_mask:0xf
    v_and_b32_dpp v95, v12, v19 row_newbcast:12 row_mask:0xf bank_mask:0xf
    v_and_b32_dpp v96, v13, v16 row_newbcast:0 row_mask:0xf bank_mask:0xf
    v_and_b32_dpp v97, v13, v17 row_newbcast:0 row_mask:0xf bank_mask:0xf
    v_and_b32_dpp v98, v13, v18 row_newbcast:0 row_mask:0xf bank_mask:0xf
    v_and_b32_dpp v99, v13, v19 row_newbcast:0 row_mask:0xf bank_mask:0xf
    v_and_b32_dpp v100, v13, v16 row_newbcast:4 row_mask:0xf bank_mask:0xf
    v_and_b32_dpp v101, v13, v17 row_newbcast:4 row_mask:0xf bank_mask:0xf
    v_and_b32_dpp v102, v13, v18 row_newbcast:4 row_mask:0xf bank_mask:0xf
    v_and_b32_dpp v103, v13, v19 row_newbcast:4 row_mask:0xf bank_mask:0xf
    v_and_b32_dpp v104, v13, v16 row_newbcast:8 row_mask:0xf bank_mask:0xf
    v_and_b32_dpp v105, v13, v17 row_newbcast:8 row_mask:0xf bank_mask:0xf
    v_and_b32_dpp v106, v13, v18 row_newbcast:8 row_mask:0xf bank_mask:0xf
    v_and_b32_dpp v107, v13, v19 row_newbcast:8 row_mask:0xf bank_mask:0xf
    v_and_b32_dpp v108, v13, v16 row_newbcast:12 row_mask:0xf bank_mask:0xf
    v_and_b32_dpp v109, v13, v17 row_newbcast:12 row_mask:0xf bank_mask:0xf
    v_and_b32_dpp v110, v13, v18 row_newbcast:12 row_mask:0xf bank_mask:0xf
    v_and_b32_dpp v111, v13, v19 row_newbcast:12 row_mask:0xf bank_mask:0xf
    v_and_b32_dpp v112, v14, v16 row_newbcast:0 row_mask:0xf bank_mask:0xf
    v_and_b32_dpp v113, v14, v17 row_newbcast:0 row_mask:0xf bank_mask:0xf
    v_and_b32_dpp v114, v14, v18 row_newbcast:0 row_mask:0xf bank_mask:0xf
    v_and_b32_dpp v115, v14, v19 row_newbcast:0 row_mask:0xf bank_mask:0xf
    v_and_b32_dpp v116, v14, v16 row_newbcast:4 row_mask:0xf bank_mask:0xf
    v_and_b32_dpp v117, v14, v17 row_newbcast:4 row_mask:0xf bank_mask:0xf
    v_and_b32_dpp v118, v14, v18 row_newbcast:4 row_mask:0xf bank_mask:0xf
    v_and_b32_dpp v119, v14, v19 row_newbcast:4 row_mask:0xf bank_mask:0xf
    v_and_b32_dpp v120, v14, v16 row_newbcast:8 row_mask:0xf bank_mask:0xf
    v_and_b32_dpp v121, v14, v17 row_newbcast:8 row_mask:0xf bank_mask:0xf
    v_and_b32_dpp v122, v14, v18 row_newbcast:8 row_mask:0xf bank_mask:0xf
    v_and_b32_dpp v123, v14, v19 row_newbcast:8 row_mask:0xf bank_mask:0xf
    v_and_b32_dpp v124, v14, v16 row_newbcast:12 row_mask:0xf bank_mask:0xf
    v_and_b32_dpp v125, v14, v17 row_newbcast:12 row_mask:0xf bank_mask:0xf
    v_and_b32_dpp v126, v14, v18 row_newbcast:12 row_mask:0xf bank_mask:0xf
    v_and_b32_dpp v127, v14, v19 row_newbcast:12 row_mask:0xf bank_mask:0xf
    v_and_b32_dpp v128, v15, v16 row_newbcast:0 row_mask:0xf bank_mask:0xf
    v_and_b32_dpp v129, v15, v17 row_newbcast:0 row_mask:0xf bank_mask:0xf
    v_and_b32_dpp v130, v15, v18 row_newbcast:0 row_mask:0xf bank_mask:0xf
    v_and_b32_dpp v131, v15, v19 row_newbcast:0 row_mask:0xf bank_mask:0xf
    v_and_b32_dpp v132, v15, v16 row_newbcast:4 row_mask:0xf bank_mask:0xf
    v_and_b32_dpp v133, v15, v17 row_newbcast:4 row_mask:0xf bank_mask:0xf
    v_and_b32_dpp v134, v15, v18 row_newbcast:4 row_mask:0xf bank_mask:0xf
    v_and_b32_dpp v135, v15, v19 row_newbcast:4 row_mask:0xf bank_mask:0xf
    v_and_b32_dpp v136, v15, v16 row_newbcast:8 row_mask:0xf bank_mask:0xf
    v_and_b32_dpp v137, v15, v17 row_newbcast:8 row_mask:0xf bank_mask:0xf
    v_and_b32_dpp v138, v15, v18 row_newbcast:8 row_mask:0xf bank_mask:0xf
    v_and_b32_dpp v139, v15, v19 row_newbcast:8 row_mask:0xf bank_mask:0xf
    v_and_b32_dpp v140, v15, v16 row_newbcast:12 row_mask:0xf bank_mask:0xf
    v_and_b32_dpp v141, v15, v17 row_newbcast:12 row_mask:0xf bank_mask:0xf
    v_and_b32_dpp v142, v15, v18 row_newbcast:12 row_mask:0xf bank_mask:0xf
    v_and_b32_dpp v143, v15, v19 row_newbcast:12 row_mask:0xf bank_mask:0xf
    s_waitcnt lgkmcnt(0)
    v_readlane_b32 s50, v4, 63
    v_pk_add_f32 v[36:37], v[36:37], v[38:39]
    s_cmp_lg_u32 s50, 3
    s_cbranch_scc1 L_NOML
    s_mov_b64 exec, 0xff
    v_add_f32 v50, v36, v37
    s_cmp_eq_u32 s47, 0
    s_cbranch_scc0 L_MLB
    buffer_store_dwordx4 v[48:51], v26, s[40:43], s59 offen
    s_branch L_MLC
L_MLB:
    buffer_store_dwordx4 v[48:51], v26, s[40:43], s58 offen sc1
L_MLC:
    s_mov_b64 exec, -1
    s_waitcnt vmcnt(16)
    v_mfma_f32_16x16x32_bf16 v[76:79], v[80:83], v[144:147], 0
    s_waitcnt vmcnt(15)
    v_mfma_f32_16x16x32_bf16 v[76:79], v[84:87], v[148:151], v[76:79]
    s_waitcnt vmcnt(14)
    v_mfma_f32_16x16x32_bf16 v[76:79], v[88:91], v[152:155], v[76:79]
    s_waitcnt vmcnt(13)
    v_mfma_f32_16x16x32_bf16 v[76:79], v[92:95], v[156:159], v[76:79]
    s_waitcnt vmcnt(12)
    v_mfma_f32_16x16x32_bf16 v[76:79], v[96:99], v[160:163], v[76:79]
    s_waitcnt vmcnt(11)
    v_mfma_f32_16x16x32_bf16 v[76:79], v[100:103], v[164:167], v[76:79]
    s_waitcnt vmcnt(10)
    v_mfma_f32_16x16x32_bf16 v[76:79], v[104:107], v[168:171], v[76:79]
    s_waitcnt vmcnt(9)
    v_mfma_f32_16x16x32_bf16 v[76:79], v[108:111], v[172:175], v[76:79]
    s_waitcnt vmcnt(8)
    v_mfma_f32_16x16x32_bf16 v[76:79], v[112:115], v[176:179], v[76:79]
    s_waitcnt vmcnt(7)
    v_mfma_f32_16x16x32_bf16 v[76:79], v[116:119], v[180:183], v[76:79]
    s_waitcnt vmcnt(6)
    v_mfma_f32_16x16x32_bf16 v[76:79], v[120:123], v[184:187], v[76:79]
    s_waitcnt vmcnt(5)
    v_mfma_f32_16x16x32_bf16 v[76:79], v[124:127], v[188:191], v[76:79]
    s_waitcnt vmcnt(4)
    v_mfma_f32_16x16x32_bf16 v[76:79], v[128:131], v[192:195], v[76:79]
    s_waitcnt vmcnt(3)
    v_mfma_f32_16x16x32_bf16 v[76:79], v[132:135], v[196:199], v[76:79]
    s_waitcnt vmcnt(2)
    v_mfma_f32_16x16x32_bf16 v[76:79], v[136:139], v[200:203], v[76:79]
    s_waitcnt vmcnt(1)
    v_mfma_f32_16x16x32_bf16 v[76:79], v[140:143], v[204:207], v[76:79]
    s_branch L_PVD
L_NOML:
    s_waitcnt vmcnt(15)
    v_mfma_f32_16x16x32_bf16 v[76:79], v[80:83], v[144:147], 0
    s_waitcnt vmcnt(14)
    v_mfma_f32_16x16x32_bf16 v[76:79], v[84:87], v[148:151], v[76:79]
    s_waitcnt vmcnt(13)
    v_mfma_f32_16x16x32_bf16 v[76:79], v[88:91], v[152:155], v[76:79]
    s_waitcnt vmcnt(12)
    v_mfma_f32_16x16x32_bf16 v[76:79], v[92:95], v[156:159], v[76:79]
    s_waitcnt vmcnt(11)
    v_mfma_f32_16x16x32_bf16 v[76:79], v[96:99], v[160:163], v[76:79]
    s_waitcnt vmcnt(10)
    v_mfma_f32_16x16x32_bf16 v[76:79], v[100:103], v[164:167], v[76:79]
    s_waitcnt vmcnt(9)
    v_mfma_f32_16x16x32_bf16 v[76:79], v[104:107], v[168:171], v[76:79]
    s_waitcnt vmcnt(8)
    v_mfma_f32_16x16x32_bf16 v[76:79], v[108:111], v[172:175], v[76:79]
    s_waitcnt vmcnt(7)
    v_mfma_f32_16x16x32_bf16 v[76:79], v[112:115], v[176:179], v[76:79]
    s_waitcnt vmcnt(6)
    v_mfma_f32_16x16x32_bf16 v[76:79], v[116:119], v[180:183], v[76:79]
    s_waitcnt vmcnt(5)
    v_mfma_f32_16x16x32_bf16 v[76:79], v[120:123], v[184:187], v[76:79]
    s_waitcnt vmcnt(4)
    v_mfma_f32_16x16x32_bf16 v[76:79], v[124:127], v[188:191], v[76:79]
    s_waitcnt vmcnt(3)
    v_mfma_f32_16x16x32_bf16 v[76:79], v[128:131], v[192:195], v[76:79]
    s_waitcnt vmcnt(2)
    v_mfma_f32_16x16x32_bf16 v[76:79], v[132:135], v[196:199], v[76:79]
    s_waitcnt vmcnt(1)
    v_mfma_f32_16x16x32_bf16 v[76:79], v[136:139], v[200:203], v[76:79]
    s_waitcnt vmcnt(0)
    v_mfma_f32_16x16x32_bf16 v[76:79], v[140:143], v[204:207], v[76:79]
L_PVD:
    s_mov_b32 exec_hi, 0
    s_nop 6
    ds_write_b128 v24, v[76:79] offset:8704
    s_mov_b64 exec, 1
    ds_add_rtn_u32 v6, v23, v27 offset:13100
    s_mov_b64 exec, -1
    ds_read2st64_b64 v[36:39], v25 offset0:17 offset1:18
    ds_read2st64_b64 v[40:43], v25 offset0:19 offset1:20
    s_waitcnt lgkmcnt(2)
    v_readfirstlane_b32 s50, v6
    s_nop 0
    s_cmp_eq_u32 s50, 3
    s_cbranch_scc0 L_EXIT
    s_waitcnt lgkmcnt(1)
    v_pk_add_f32 v[36:37], v[36:37], v[38:39]
    s_waitcnt lgkmcnt(0)
    v_pk_add_f32 v[40:41], v[40:41], v[42:43]
    v_add_f32 v44, v36, v40
    v_add_f32 v46, v37, v41
    s_cmp_eq_u32 s47, 0
    s_cbranch_scc0 L_OB
    buffer_store_dwordx4 v[44:47], v26, s[40:43], s57 offen
    s_branch L_EXIT
L_OB:
    buffer_store_dwordx4 v[44:47], v26, s[40:43], s56 offen sc1
L_EXIT:
L_END:
    s_endpgm
.section .rodata,"a"
.p2align 6
.amdhsa_kernel parallel_sum__sliding_block_cached__dense_activation_gelu__decode_kernel
  .amdhsa_next_free_vgpr 212
  .amdhsa_next_free_sgpr 72
  .amdhsa_accum_offset 212
  .amdhsa_group_segment_fixed_size 0
  .amdhsa_kernarg_size 104
  .amdhsa_user_sgpr_count 2
  .amdhsa_user_sgpr_kernarg_segment_ptr 1
  .amdhsa_system_sgpr_workgroup_id_x 1
.end_amdhsa_kernel
```
